```python
import torch

def _softmax(x, axis=-1):
    return torch.softmax(x, dim=axis)

def _gelu(x):
    return torch.nn.functional.gelu(x, approximate='tanh')

def _silu(x):
    return torch.nn.functional.silu(x)

def _sigmoid(x):
    return torch.sigmoid(x)

def _layernorm(x, axis=-1, eps=1e-05):
    m = x.mean(dim=axis, keepdim=True)
    v = x.var(dim=axis, keepdim=True, unbiased=False)
    return (x - m) / torch.sqrt(v + eps)

def _scatter_add(tgt, idx, src, axis=0):
    return tgt.clone().index_add_(axis, idx, src)

def _segment_sum(src, seg, n):
    out = torch.zeros((n,) + src.shape[1:], dtype=src.dtype)
    return out.index_add_(0, seg, src)

def _pad(x, pw):
    flat = tuple((v for pair in reversed(pw) for v in pair))
    return torch.nn.functional.pad(x, flat)
kernel_name = 'standalone__tree_speculative_verify_tree_attention_over_candidate_token_tree__decode'

def setup_inputs():

    _w = lambda a: (lambda t: t.to(torch.bfloat16) if t.is_floating_point() else t)(torch.as_tensor(a))
    B, Hq, Hkv, T, C, D = (2, 32, 4, 1, 16384, 128)
    tree_mask = torch.zeros((B, T, T), dtype=float)
    for b in range(B):
        parent = torch.zeros(T, dtype=torch.int64)
        for i in range(1, T):
            parent[i] = int(torch.randint(0, i, (1,)).item())
        for i in range(T):
            j = i
            tree_mask[b, i, j] = 1.0
            while j > 0:
                j = parent[j]
                tree_mask[b, i, j] = 1.0
    return {'q': _w((lambda *s: torch.randn(*s, dtype=torch.bfloat16) * 0.8)(B, Hq, T, D)), 'k_cache': _w((lambda *s: torch.randn(*s, dtype=torch.bfloat16) * 0.8)(B, Hkv, C, D)), 'v_cache': _w((lambda *s: torch.randn(*s, dtype=torch.bfloat16) * 0.05)(B, Hkv, C, D)), 'k_tree': _w((lambda *s: torch.randn(*s, dtype=torch.bfloat16) * 0.8)(B, Hkv, T, D)), 'v_tree': _w((lambda *s: torch.randn(*s, dtype=torch.bfloat16) * 0.05)(B, Hkv, T, D)), 'tree_mask': _w(tree_mask)}

def reference(q, k_cache, v_cache, k_tree, v_tree, tree_mask):
    B, Hq, T, D = q.shape
    Hkv, C = (k_cache.shape[1], k_cache.shape[2])
    rep = Hq // Hkv
    kc = (lambda x, n, axis: torch.repeat_interleave(x, n, dim=axis))(k_cache, rep, axis=1)
    vc = (lambda x, n, axis: torch.repeat_interleave(x, n, dim=axis))(v_cache, rep, axis=1)
    kt = (lambda x, n, axis: torch.repeat_interleave(x, n, dim=axis))(k_tree, rep, axis=1)
    vt = (lambda x, n, axis: torch.repeat_interleave(x, n, dim=axis))(v_tree, rep, axis=1)
    k = torch.concatenate([kc, kt], axis=2)
    v = torch.concatenate([vc, vt], axis=2)
    scale = D ** (-0.5)
    scores = torch.einsum('bhqd,bhkd->bhqk', q, k) * scale
    ctx_mask = torch.ones((B, 1, T, C), dtype=scores.dtype)
    tm = tree_mask[:, None, :, :].clone()
    full_mask = torch.concatenate([ctx_mask, tm], axis=-1)
    scores = scores + (1.0 - full_mask) * -1000000000.0
    p = _softmax(scores, axis=-1)
    return torch.einsum('bhqk,bhkd->bhqd', p, v)
```

```asm
; @launch grid=(256,1,1) block=(512,1,1) lds=34304
.amdgcn_target "amdgcn-amd-amdhsa--gfx950"
.text
.globl standalone__tree_speculative_verify_tree_attention_over_candidate_token_tree__decode_kernel
.p2align 8
.type standalone__tree_speculative_verify_tree_attention_over_candidate_token_tree__decode_kernel,@function
standalone__tree_speculative_verify_tree_attention_over_candidate_token_tree__decode_kernel:
    s_cmp_ge_u32 s2, 256
    s_cbranch_scc1 k_end
    s_load_dwordx2 s[28:29], s[0:1], 8
    s_load_dwordx2 s[24:25], s[0:1], 0
    s_load_dwordx2 s[32:33], s[0:1], 16
    s_load_dwordx2 s[16:17], s[0:1], 64
    v_lshrrev_b32 v1, 6, v0
    v_and_b32 v2, 63, v0
    v_readfirstlane_b32 s3, v1
    v_bfe_u32 v4, v0, 4, 2
    v_bfe_u32 v5, v0, 1, 1
    v_lshlrev_b32 v5, 10, v5
    v_bfe_u32 v6, v0, 2, 2
    v_lshl_or_b32 v5, v6, 8, v5
    v_lshl_or_b32 v5, v4, 5, v5
    v_and_b32 v6, 1, v0
    v_lshl_or_b32 v5, v6, 4, v5
    v_and_b32 v3, 7, v0
    v_lshlrev_b32 v7, 8, v3
    v_lshl_or_b32 v7, v4, 5, v7
    v_bfe_u32 v6, v0, 3, 1
    v_lshl_or_b32 v7, v6, 4, v7
    v_lshlrev_b32 v6, 4, v2
    s_mov_b32 s26, 16384
    s_mov_b32 s27, 0x00020000
    s_mov_b32 s30, 0x02000000
    s_mov_b32 s31, 0x00020000
    s_mov_b32 s34, 0x02000000
    s_mov_b32 s35, 0x00020000
    s_lshr_b32 s44, s2, 5
    s_and_b32 s45, s2, 31
    s_lshl_b32 s40, s2, 17
    s_lshl_b32 s41, s3, 12
    s_add_u32 s40, s40, s41
    s_cmp_ge_u32 s3, 4
    s_cselect_b32 s41, 262144, 0
    s_xor_b32 s40, s40, s41
    s_lshl_b32 s49, s44, 11
    s_waitcnt lgkmcnt(0)
    buffer_load_dwordx4 v[8:11], v7, s[24:27], s49 offen offset:0
    buffer_load_dwordx4 v[12:15], v7, s[24:27], s49 offen offset:128
    buffer_load_dwordx4 v[16:19], v5, s[28:31], s40 offen offset:0 nt
    buffer_load_dwordx4 v[20:23], v5, s[28:31], s40 offen offset:128 nt
    buffer_load_dwordx4 v[24:27], v5, s[28:31], s40 offen offset:2048 nt
    buffer_load_dwordx4 v[28:31], v5, s[28:31], s40 offen offset:2176 nt
    s_xor_b32 s41, s40, 32768
    buffer_load_dwordx4 v[32:35], v5, s[28:31], s41 offen offset:0 nt
    buffer_load_dwordx4 v[36:39], v5, s[28:31], s41 offen offset:128 nt
    buffer_load_dwordx4 v[40:43], v5, s[28:31], s41 offen offset:2048 nt
    buffer_load_dwordx4 v[44:47], v5, s[28:31], s41 offen offset:2176 nt
    s_xor_b32 s41, s40, 65536
    buffer_load_dwordx4 v[48:51], v5, s[28:31], s41 offen offset:0 nt
    buffer_load_dwordx4 v[52:55], v5, s[28:31], s41 offen offset:128 nt
    buffer_load_dwordx4 v[56:59], v5, s[28:31], s41 offen offset:2048 nt
    buffer_load_dwordx4 v[60:63], v5, s[28:31], s41 offen offset:2176 nt
    s_xor_b32 s41, s40, 98304
    buffer_load_dwordx4 v[64:67], v5, s[28:31], s41 offen offset:0 nt
    buffer_load_dwordx4 v[68:71], v5, s[28:31], s41 offen offset:128 nt
    buffer_load_dwordx4 v[72:75], v5, s[28:31], s41 offen offset:2048 nt
    buffer_load_dwordx4 v[76:79], v5, s[28:31], s41 offen offset:2176 nt
    s_mov_b32 s46, 0x3e0293ee
    buffer_load_dwordx4 v[80:83], v6, s[32:35], s40 offen offset:0 nt
    buffer_load_dwordx4 v[84:87], v6, s[32:35], s40 offen offset:1024 nt
    buffer_load_dwordx4 v[88:91], v6, s[32:35], s40 offen offset:2048 nt
    buffer_load_dwordx4 v[92:95], v6, s[32:35], s40 offen offset:3072 nt
    s_xor_b32 s41, s40, 32768
    buffer_load_dwordx4 v[96:99], v6, s[32:35], s41 offen offset:0 nt
    buffer_load_dwordx4 v[100:103], v6, s[32:35], s41 offen offset:1024 nt
    buffer_load_dwordx4 v[104:107], v6, s[32:35], s41 offen offset:2048 nt
    buffer_load_dwordx4 v[108:111], v6, s[32:35], s41 offen offset:3072 nt
    s_xor_b32 s41, s40, 65536
    buffer_load_dwordx4 v[112:115], v6, s[32:35], s41 offen offset:0 nt
    buffer_load_dwordx4 v[116:119], v6, s[32:35], s41 offen offset:1024 nt
    buffer_load_dwordx4 v[120:123], v6, s[32:35], s41 offen offset:2048 nt
    buffer_load_dwordx4 v[124:127], v6, s[32:35], s41 offen offset:3072 nt
    s_xor_b32 s41, s40, 98304
    buffer_load_dwordx4 v[128:131], v6, s[32:35], s41 offen offset:0 nt
    buffer_load_dwordx4 v[132:135], v6, s[32:35], s41 offen offset:1024 nt
    buffer_load_dwordx4 v[136:139], v6, s[32:35], s41 offen offset:2048 nt
    buffer_load_dwordx4 v[140:143], v6, s[32:35], s41 offen offset:3072 nt
    s_lshl_b32 s54, s44, 7
    s_add_u32 s54, s54, 1146880
    s_load_dword s63, s[16:17], s54
    s_mov_b32 s47, 0x05040100
    s_mov_b32 s48, 0x07060302
    s_cmp_ge_u32 s3, 4
    s_cselect_b32 s50, 1, 0
    s_mul_i32 s51, s3, 4224
    v_lshlrev_b32 v1, 3, v1
    v_lshl_add_u32 v1, v3, 6, v1
    v_lshlrev_b32 v4, 7, v4
    v_mul_u32_u24 v3, 528, v3
    v_add3_u32 v4, v4, v3, s51
    s_waitcnt vmcnt(30)
    v_mfma_f32_16x16x32_bf16 v[144:147], v[16:19], v[8:11], 0
    v_mfma_f32_16x16x32_bf16 v[144:147], v[20:23], v[12:15], v[144:147]
    s_waitcnt vmcnt(28)
    v_mfma_f32_16x16x32_bf16 v[16:19], v[24:27], v[8:11], 0
    v_mfma_f32_16x16x32_bf16 v[16:19], v[28:31], v[12:15], v[16:19]
    s_waitcnt vmcnt(26)
    v_mfma_f32_16x16x32_bf16 v[24:27], v[32:35], v[8:11], 0
    v_mfma_f32_16x16x32_bf16 v[24:27], v[36:39], v[12:15], v[24:27]
    s_waitcnt vmcnt(24)
    v_mfma_f32_16x16x32_bf16 v[32:35], v[40:43], v[8:11], 0
    v_mfma_f32_16x16x32_bf16 v[32:35], v[44:47], v[12:15], v[32:35]
    s_waitcnt vmcnt(22)
    v_mfma_f32_16x16x32_bf16 v[40:43], v[48:51], v[8:11], 0
    v_mfma_f32_16x16x32_bf16 v[40:43], v[52:55], v[12:15], v[40:43]
    v_add_f32 v148, v145, v144 row_ror:8 row_mask:0xf bank_mask:0x3
    v_add_f32 v149, v147, v146 row_ror:8 row_mask:0xf bank_mask:0x3
    s_waitcnt vmcnt(20)
    v_mfma_f32_16x16x32_bf16 v[48:51], v[56:59], v[8:11], 0
    v_mfma_f32_16x16x32_bf16 v[48:51], v[60:63], v[12:15], v[48:51]
    v_add_f32 v150, v17, v16 row_ror:8 row_mask:0xf bank_mask:0x3
    v_add_f32 v151, v19, v18 row_ror:8 row_mask:0xf bank_mask:0x3
    s_waitcnt vmcnt(18)
    v_mfma_f32_16x16x32_bf16 v[56:59], v[64:67], v[8:11], 0
    v_mfma_f32_16x16x32_bf16 v[56:59], v[68:71], v[12:15], v[56:59]
    v_add_f32 v152, v25, v24 row_ror:8 row_mask:0xf bank_mask:0x3
    v_add_f32 v153, v27, v26 row_ror:8 row_mask:0xf bank_mask:0x3
    s_waitcnt vmcnt(16)
    v_mfma_f32_16x16x32_bf16 v[64:67], v[72:75], v[8:11], 0
    v_mfma_f32_16x16x32_bf16 v[64:67], v[76:79], v[12:15], v[64:67]
    v_add_f32 v154, v33, v32 row_ror:8 row_mask:0xf bank_mask:0x3
    v_add_f32 v155, v35, v34 row_ror:8 row_mask:0xf bank_mask:0x3
    v_add_f32 v148, v40, v41 row_ror:8 row_mask:0xf bank_mask:0xc
    v_add_f32 v149, v42, v43 row_ror:8 row_mask:0xf bank_mask:0xc
    v_add_f32 v150, v48, v49 row_ror:8 row_mask:0xf bank_mask:0xc
    v_add_f32 v151, v50, v51 row_ror:8 row_mask:0xf bank_mask:0xc
    v_add_f32 v152, v56, v57 row_ror:8 row_mask:0xf bank_mask:0xc
    v_add_f32 v153, v58, v59 row_ror:8 row_mask:0xf bank_mask:0xc
    v_add_f32 v154, v64, v65 row_ror:8 row_mask:0xf bank_mask:0xc
    v_add_f32 v155, v66, v67 row_ror:8 row_mask:0xf bank_mask:0xc
    v_max3_f32 v164, v148, v149, v150
    v_max3_f32 v165, v151, v152, v153
    v_max3_f32 v164, v164, v154, v155
    v_max_f32 v164, v164, v165
    s_nop 1
    v_max_f32 v164, v164, v164 row_ror:8
    v_mov_b32 v165, v164
    s_nop 1
    v_permlane16_swap_b32 v164, v165
    v_max_f32 v164, v164, v165
    v_mov_b32 v165, v164
    s_nop 1
    v_permlane32_swap_b32 v164, v165
    v_max_f32 v164, v164, v165
    v_mul_f32 v166, s46, v164
    v_fma_f32 v148, v148, s46, -v166
    v_fma_f32 v149, v149, s46, -v166
    v_fma_f32 v150, v150, s46, -v166
    v_fma_f32 v151, v151, s46, -v166
    v_fma_f32 v152, v152, s46, -v166
    v_fma_f32 v153, v153, s46, -v166
    v_fma_f32 v154, v154, s46, -v166
    v_fma_f32 v155, v155, s46, -v166
    v_exp_f32 v148, v148
    v_exp_f32 v149, v149
    v_exp_f32 v150, v150
    v_exp_f32 v151, v151
    v_exp_f32 v152, v152
    v_exp_f32 v153, v153
    v_exp_f32 v154, v154
    v_exp_f32 v155, v155
    s_nop 0
    v_cvt_pk_bf16_f32 v156, v148, v149
    v_cvt_pk_bf16_f32 v157, v150, v151
    v_cvt_pk_bf16_f32 v158, v152, v153
    v_cvt_pk_bf16_f32 v159, v154, v155
    v_add_f32 v164, v148, v149
    v_add_f32 v165, v150, v151
    v_add_f32 v164, v164, v152
    v_add_f32 v165, v165, v153
    v_add_f32 v164, v164, v154
    v_add_f32 v165, v165, v155
    v_add_f32 v167, v164, v165
    v_mov_b32 v160, v156 row_ror:8
    v_mov_b32 v161, v157 row_ror:8
    v_add_f32 v167, v167, v167 row_ror:8
    v_mov_b32 v162, v158 row_ror:8
    v_mov_b32 v163, v159 row_ror:8
    v_mov_b32 v165, v167
    s_nop 1
    v_permlane16_swap_b32 v167, v165
    v_add_f32 v167, v167, v165
    v_mov_b32 v165, v167
    s_nop 1
    v_permlane32_swap_b32 v167, v165
    v_add_f32 v167, v167, v165
    s_mov_b64 exec, 0xff
    ds_write_b64 v1, v[166:167] offset:33792
    s_mov_b64 exec, -1
    s_cmp_eq_u32 s50, 0
    s_cbranch_scc1 k_noA
    s_waitcnt lgkmcnt(0)
    s_barrier
k_noA:
    s_waitcnt vmcnt(14)
    v_perm_b32 v16, v84, v80, s47
    v_perm_b32 v20, v84, v80, s48
    v_perm_b32 v24, v85, v81, s47
    v_perm_b32 v28, v85, v81, s48
    v_perm_b32 v32, v86, v82, s47
    v_perm_b32 v36, v86, v82, s48
    v_perm_b32 v40, v87, v83, s47
    v_perm_b32 v44, v87, v83, s48
    s_waitcnt vmcnt(12)
    v_perm_b32 v17, v92, v88, s47
    v_perm_b32 v21, v92, v88, s48
    v_perm_b32 v25, v93, v89, s47
    v_perm_b32 v29, v93, v89, s48
    v_perm_b32 v33, v94, v90, s47
    v_perm_b32 v37, v94, v90, s48
    v_perm_b32 v41, v95, v91, s47
    v_perm_b32 v45, v95, v91, s48
    s_waitcnt vmcnt(10)
    v_perm_b32 v18, v100, v96, s47
    v_perm_b32 v22, v100, v96, s48
    v_perm_b32 v26, v101, v97, s47
    v_perm_b32 v30, v101, v97, s48
    v_perm_b32 v34, v102, v98, s47
    v_perm_b32 v38, v102, v98, s48
    v_perm_b32 v42, v103, v99, s47
    v_perm_b32 v46, v103, v99, s48
    s_waitcnt vmcnt(8)
    v_perm_b32 v19, v108, v104, s47
    v_perm_b32 v23, v108, v104, s48
    v_perm_b32 v27, v109, v105, s47
    v_mfma_f32_16x16x32_bf16 v[48:51], v[16:19], v[156:159], 0
    v_perm_b32 v31, v109, v105, s48
    v_mfma_f32_16x16x32_bf16 v[52:55], v[20:23], v[156:159], 0
    v_perm_b32 v35, v110, v106, s47
    v_mfma_f32_16x16x32_bf16 v[56:59], v[24:27], v[156:159], 0
    v_perm_b32 v39, v110, v106, s48
    v_mfma_f32_16x16x32_bf16 v[60:63], v[28:31], v[156:159], 0
    v_perm_b32 v43, v111, v107, s47
    v_mfma_f32_16x16x32_bf16 v[64:67], v[32:35], v[156:159], 0
    v_perm_b32 v47, v111, v107, s48
    v_mfma_f32_16x16x32_bf16 v[68:71], v[36:39], v[156:159], 0
    s_nop 0
    v_mfma_f32_16x16x32_bf16 v[72:75], v[40:43], v[156:159], 0
    v_mfma_f32_16x16x32_bf16 v[76:79], v[44:47], v[156:159], 0
    s_waitcnt vmcnt(6)
    v_perm_b32 v80, v116, v112, s47
    v_perm_b32 v84, v116, v112, s48
    v_perm_b32 v88, v117, v113, s47
    v_perm_b32 v92, v117, v113, s48
    v_perm_b32 v96, v118, v114, s47
    v_perm_b32 v100, v118, v114, s48
    v_perm_b32 v104, v119, v115, s47
    v_perm_b32 v108, v119, v115, s48
    s_waitcnt vmcnt(4)
    v_perm_b32 v81, v124, v120, s47
    v_perm_b32 v85, v124, v120, s48
    v_perm_b32 v89, v125, v121, s47
    v_perm_b32 v93, v125, v121, s48
    v_perm_b32 v97, v126, v122, s47
    v_perm_b32 v101, v126, v122, s48
    v_perm_b32 v105, v127, v123, s47
    v_perm_b32 v109, v127, v123, s48
    s_waitcnt vmcnt(2)
    v_perm_b32 v82, v132, v128, s47
    v_perm_b32 v86, v132, v128, s48
    v_perm_b32 v90, v133, v129, s47
    v_perm_b32 v94, v133, v129, s48
    v_perm_b32 v98, v134, v130, s47
    v_perm_b32 v102, v134, v130, s48
    v_perm_b32 v106, v135, v131, s47
    v_perm_b32 v110, v135, v131, s48
    s_waitcnt vmcnt(0)
    v_perm_b32 v83, v140, v136, s47
    v_perm_b32 v87, v140, v136, s48
    v_perm_b32 v91, v141, v137, s47
    v_mfma_f32_16x16x32_bf16 v[48:51], v[80:83], v[160:163], v[48:51]
    v_perm_b32 v95, v141, v137, s48
    v_mfma_f32_16x16x32_bf16 v[52:55], v[84:87], v[160:163], v[52:55]
    v_perm_b32 v99, v142, v138, s47
    v_mfma_f32_16x16x32_bf16 v[56:59], v[88:91], v[160:163], v[56:59]
    v_perm_b32 v103, v142, v138, s48
    v_mfma_f32_16x16x32_bf16 v[60:63], v[92:95], v[160:163], v[60:63]
    v_perm_b32 v107, v143, v139, s47
    v_mfma_f32_16x16x32_bf16 v[64:67], v[96:99], v[160:163], v[64:67]
    v_perm_b32 v111, v143, v139, s48
    v_mfma_f32_16x16x32_bf16 v[68:71], v[100:103], v[160:163], v[68:71]
    s_nop 0
    v_mfma_f32_16x16x32_bf16 v[72:75], v[104:107], v[160:163], v[72:75]
    v_mfma_f32_16x16x32_bf16 v[76:79], v[108:111], v[160:163], v[76:79]
    s_mov_b32 exec_lo, 0x00ff00ff
    s_mov_b32 exec_hi, 0x00ff00ff
    ds_write_b128 v4, v[48:51] offset:0
    ds_write_b128 v4, v[52:55] offset:16
    ds_write_b128 v4, v[56:59] offset:32
    ds_write_b128 v4, v[60:63] offset:48
    ds_write_b128 v4, v[64:67] offset:64
    ds_write_b128 v4, v[68:71] offset:80
    s_nop 0
    ds_write_b128 v4, v[72:75] offset:96
    ds_write_b128 v4, v[76:79] offset:112
    s_mov_b64 exec, -1
    s_cmp_eq_u32 s50, 0
    s_cbranch_scc1 k_early
    s_waitcnt lgkmcnt(0)
    s_barrier
k_end:
    s_endpgm
k_early:
    s_mov_b32 s18, 1147904
    s_mov_b32 s19, 0x00020000
    s_lshr_b32 s53, s45, 3
    s_cmp_eq_u32 s3, 0
    s_cselect_b32 s55, 1, 0
    s_mov_b32 s64, 0
    s_cbranch_scc0 k_noprep
    s_load_dwordx2 s[36:37], s[0:1], 24
    s_load_dwordx2 s[8:9], s[0:1], 32
    s_load_dwordx2 s[6:7], s[0:1], 40
    s_load_dwordx2 s[12:13], s[0:1], 48
    s_mov_b32 s38, 2048
    s_mov_b32 s39, 0x00020000
    s_mov_b32 s10, 2048
    s_mov_b32 s11, 0x00020000
    s_mov_b32 s14, 16384
    s_mov_b32 s15, 0x00020000
    s_lshr_b32 s65, s45, 2
    s_lshl_b32 s56, s65, 8
    s_add_u32 s56, s56, s49
    s_lshl_b32 s57, s44, 8
    s_and_b32 s58, s45, 3
    s_lshl_b32 s58, s58, 6
    s_add_u32 s59, s58, s57
    s_add_u32 s58, s58, s56
    v_lshlrev_b32 v60, 2, v2
    v_and_b32 v59, 7, v2
    v_lshlrev_b32 v57, 4, v59
    v_lshlrev_b32 v59, 1, v59
    v_mov_b32 v52, 0
    v_mov_b32 v53, 0
    v_mov_b32 v54, 0
    v_mov_b32 v55, 0
    s_waitcnt lgkmcnt(0)
    s_load_dword s6, s[6:7], 0
    buffer_load_dword v45, v60, s[24:27], s56 offen
    buffer_load_dword v46, v60, s[36:39], s57 offen
    s_mov_b64 exec, 0xff
    buffer_load_short_d16_hi v52, v59, s[8:11], s59 offen offset:0
    buffer_load_short_d16_hi v53, v59, s[8:11], s59 offen offset:16
    buffer_load_short_d16_hi v54, v59, s[8:11], s59 offen offset:32
    buffer_load_short_d16_hi v55, v59, s[8:11], s59 offen offset:48
    s_mov_b64 exec, -1
    v_lshrrev_b32 v61, 3, v2
    v_and_b32 v58, 3, v2
    v_lshl_add_u32 v58, v58, 3, v61
    v_lshlrev_b32 v58, 4, v58
    v_mul_u32_u24 v61, 4352, v61
    v_add_u32 v57, v57, v61
    v_mov_b32 v60, 48
    v_and_or_b32 v59, v2, v60, v59
    s_mul_i32 s66, s44, 139264
    s_lshl_b32 s56, s56, 1
    s_add_u32 s56, s56, 1114112
    s_lshl_b32 s67, s45, 7
    s_add_u32 s66, s66, s67
    s_add_u32 s67, s66, 34816
    s_add_u32 s68, s66, 69632
    s_add_u32 s69, s66, 104448
    s_mov_b32 s7, 0xceabfb8f
    s_movk_i32 s57, 1023
    v_mov_b32 v12, 0
    s_waitcnt lgkmcnt(0)
    s_lshl_b32 s5, s6, 16
    s_and_b32 s6, s6, 0xffff0000
    s_cmp_ge_u32 s44, 4
    s_cselect_b32 s6, s6, s5
    v_mov_b32 v56, s6
    v_sub_f32 v56, 1.0, v56
    v_mul_f32 v56, s7, v56
    s_add_u32 s5, s63, 1
    v_mov_b32 v11, s5
    s_waitcnt vmcnt(0)
    v_lshlrev_b32 v60, 16, v45
    v_lshlrev_b32 v61, 16, v46
    v_and_b32 v45, 0xffff0000, v45
    v_and_b32 v46, 0xffff0000, v46
    v_mul_f32 v60, v60, v61
    v_fma_f32 v60, v45, v46, v60
    s_nop 1
    v_add_f32 v60, v60, v60 quad_perm:[1,0,3,2]
    s_nop 1
    v_add_f32 v60, v60, v60 quad_perm:[2,3,0,1]
    s_nop 1
    v_add_f32 v60, v60, v60 row_half_mirror
    s_nop 1
    v_add_f32 v60, v60, v60 row_mirror
    v_mov_b32 v61, v60
    s_nop 1
    v_permlane16_swap_b32 v60, v61
    v_add_f32 v60, v60, v61
    v_mov_b32 v61, v60
    s_nop 1
    v_permlane32_swap_b32 v60, v61
    v_add_f32 v60, v60, v61
    v_fma_f32 v56, v60, s46, v56
    s_mov_b64 s[90:91], -1
    s_mov_b64 s[92:93], -1
    s_mov_b64 s[94:95], -1
    s_mov_b64 s[96:97], -1
    s_mov_b64 s[98:99], -1
    s_mov_b64 s[20:21], 1
    s_mov_b64 s[22:23], 0
    s_mov_b32 s42, 0x00ff00ff
    s_mov_b32 s43, 0x00ff00ff
    s_cmp_eq_u32 s45, 0
    s_cselect_b64 s[88:89], 1, 0
    s_mov_b32 s60, 1
    s_mov_b32 s61, 0
    v_mov_b32 v84, s63
    v_mov_b32 v88, s63
    v_mov_b32 v92, s63
    v_mov_b32 v96, s63
    v_mov_b32 v100, s63
k_noprep:
    v_lshrrev_b32 v9, 5, v2
    s_lshl_b32 s5, s3, 1
    v_add_u32 v8, s5, v9
    v_lshlrev_b32 v164, 6, v8
    v_mul_u32_u24 v8, 528, v8
    v_and_b32 v165, 31, v2
    v_lshl_add_u32 v8, v165, 4, v8
    v_lshlrev_b32 v9, 9, v9
    v_mov_b32 v10, 0xfffffc00
    s_mul_i32 s51, s2, 4352
    s_lshl_b32 s52, s49, 1
    s_lshl_b32 s5, s45, 4
    s_add_u32 s52, s52, s5
    s_lshl_b32 s5, s3, 10
    s_add_u32 s52, s52, s5
    s_add_u32 s52, s52, 1114112
    s_add_u32 s51, s51, s5
    v_mov_b32 v160, 0
    v_mov_b32 v161, 0
    v_mov_b32 v162, 0
    v_mov_b32 v163, 0
    s_mov_b64 s[70:71], 0
    s_waitcnt lgkmcnt(0)
    s_add_u32 s62, s63, 1
    s_and_b32 s62, s62, 1023
    s_barrier
    ds_read_b128 v[128:131], v164 offset:33792
    ds_read_b128 v[132:135], v164 offset:33808
    ds_read_b128 v[136:139], v164 offset:33824
    ds_read_b128 v[140:143], v164 offset:33840
    v_mov_b32 v167, s62
    s_waitcnt lgkmcnt(0)
    v_max3_f32 v164, v128, v130, v132
    v_max3_f32 v165, v134, v136, v138
    v_max3_f32 v164, v164, v140, v142
    v_max_f32 v164, v164, v165
    v_sub_f32 v128, v128, v164
    v_sub_f32 v130, v130, v164
    v_sub_f32 v132, v132, v164
    v_sub_f32 v134, v134, v164
    v_sub_f32 v136, v136, v164
    v_sub_f32 v138, v138, v164
    v_sub_f32 v140, v140, v164
    v_sub_f32 v142, v142, v164
    v_exp_f32 v128, v128
    v_exp_f32 v130, v130
    v_exp_f32 v132, v132
    v_exp_f32 v134, v134
    v_exp_f32 v136, v136
    v_exp_f32 v138, v138
    v_exp_f32 v140, v140
    v_exp_f32 v142, v142
    v_lshl_or_b32 v166, v164, 10, s62
    v_and_or_b32 v164, v164, v10, s62
    v_mul_f32 v165, v128, v129
    v_fma_f32 v165, v130, v131, v165
    v_fma_f32 v165, v132, v133, v165
    v_fma_f32 v165, v134, v135, v165
    v_fma_f32 v165, v136, v137, v165
    v_fma_f32 v165, v138, v139, v165
    v_fma_f32 v165, v140, v141, v165
    v_fma_f32 v165, v142, v143, v165
    s_mov_b32 exec_lo, 1
    s_mov_b32 exec_hi, 1
    v_and_or_b32 v165, v165, v10, s62
    buffer_store_dwordx4 v[164:167], v9, s[16:19], s52 offen sc1
    s_mov_b64 exec, -1
    s_branch k_red
k_barb:
    s_barrier
k_red:
    ds_read_b128 v[144:147], v8 offset:0
    ds_read_b128 v[148:151], v8 offset:4224
    ds_read_b128 v[152:155], v8 offset:8448
    ds_read_b128 v[156:159], v8 offset:12672
    s_waitcnt lgkmcnt(3)
    v_pk_fma_f32 v[160:161], v[144:145], v[128:129], v[160:161] op_sel_hi:[1,0,1]
    v_pk_fma_f32 v[162:163], v[146:147], v[128:129], v[162:163] op_sel_hi:[1,0,1]
    s_waitcnt lgkmcnt(2)
    v_pk_fma_f32 v[160:161], v[148:149], v[130:131], v[160:161] op_sel_hi:[1,0,1]
    v_pk_fma_f32 v[162:163], v[150:151], v[130:131], v[162:163] op_sel_hi:[1,0,1]
    s_waitcnt lgkmcnt(1)
    v_pk_fma_f32 v[160:161], v[152:153], v[132:133], v[160:161] op_sel_hi:[1,0,1]
    v_pk_fma_f32 v[162:163], v[154:155], v[132:133], v[162:163] op_sel_hi:[1,0,1]
    s_waitcnt lgkmcnt(0)
    v_pk_fma_f32 v[160:161], v[156:157], v[134:135], v[160:161] op_sel_hi:[1,0,1]
    v_pk_fma_f32 v[162:163], v[158:159], v[134:135], v[162:163] op_sel_hi:[1,0,1]
    s_mov_b64 exec, s[70:71]
    v_and_or_b32 v160, v160, v10, s62
    v_and_or_b32 v161, v161, v10, s62
    v_and_or_b32 v162, v162, v10, s62
    v_and_or_b32 v163, v163, v10, s62
    buffer_store_dwordx4 v[160:163], v6, s[16:19], s51 offen sc1
    s_cbranch_execnz k_post
    s_mov_b64 exec, -1
    s_mov_b64 s[70:71], -1
    v_mov_b32 v128, v136
    v_mov_b32 v130, v138
    v_mov_b32 v132, v140
    v_mov_b32 v134, v142
    v_add_u32 v8, 16896, v8
    s_cmp_eq_u32 s55, 0
    s_cbranch_scc1 k_barb
    buffer_load_dwordx4 v[80:83], v58, s[16:19], s56 offen sc1
    buffer_load_dwordx4 v[64:67], v57, s[16:19], s66 offen sc1
    buffer_load_dwordx4 v[68:71], v57, s[16:19], s67 offen sc1
    buffer_load_dwordx4 v[72:75], v57, s[16:19], s68 offen sc1
    buffer_load_dwordx4 v[76:79], v57, s[16:19], s69 offen sc1
    s_branch k_barb
k_post:
    s_cmp_eq_u32 s55, 0
    s_cbranch_scc1 k_end
    s_waitcnt vmcnt(1)
k_r0:
    s_mov_b64 exec, s[98:99]
    s_cbranch_execz k_x0_4
    v_xor_b32 v32, s62, v80
    v_xor_b32 v33, s62, v81
    v_xor_b32 v34, s62, v82
    v_xor_b32 v35, s62, v83
    v_or3_b32 v60, v32, v33, v34
    v_bitop3_b32 v60, v60, v35, s57 bitop3:0xa8
    v_cmp_ne_u32 s[98:99], 0, v60
k_x0_4:
    s_or_b64 s[4:5], s[98:99], s[22:23]
    s_mov_b64 exec, s[90:91]
    s_cbranch_execz k_x0_0
    v_xor_b32 v16, s62, v64
    v_xor_b32 v17, s62, v65
    v_xor_b32 v18, s62, v66
    v_xor_b32 v19, s62, v67
    v_or3_b32 v60, v16, v17, v18
    v_bitop3_b32 v60, v60, v19, s57 bitop3:0xa8
    v_cmp_ne_u32 s[90:91], 0, v60
k_x0_0:
    s_or_b64 s[4:5], s[90:91], s[4:5]
    s_mov_b64 exec, s[92:93]
    s_cbranch_execz k_x0_1
    v_xor_b32 v20, s62, v68
    v_xor_b32 v21, s62, v69
    v_xor_b32 v22, s62, v70
    v_xor_b32 v23, s62, v71
    v_or3_b32 v60, v20, v21, v22
    v_bitop3_b32 v60, v60, v23, s57 bitop3:0xa8
    v_cmp_ne_u32 s[92:93], 0, v60
k_x0_1:
    s_or_b64 s[4:5], s[92:93], s[4:5]
    s_mov_b64 exec, s[94:95]
    s_cbranch_execz k_x0_2
    v_xor_b32 v24, s62, v72
    v_xor_b32 v25, s62, v73
    v_xor_b32 v26, s62, v74
    v_xor_b32 v27, s62, v75
    v_or3_b32 v60, v24, v25, v26
    v_bitop3_b32 v60, v60, v27, s57 bitop3:0xa8
    v_cmp_ne_u32 s[94:95], 0, v60
k_x0_2:
    s_or_b64 s[4:5], s[94:95], s[4:5]
    s_mov_b64 exec, s[96:97]
    s_cbranch_execz k_x0_3
    v_xor_b32 v28, s62, v76
    v_xor_b32 v29, s62, v77
    v_xor_b32 v30, s62, v78
    v_xor_b32 v31, s62, v79
    v_or3_b32 v60, v28, v29, v30
    v_bitop3_b32 v60, v60, v31, s57 bitop3:0xa8
    v_cmp_ne_u32 s[96:97], 0, v60
k_x0_3:
    s_or_b64 s[4:5], s[96:97], s[4:5]
    s_cbranch_scc0 k_done
    s_or_b64 exec, s[98:99], s[20:21]
    buffer_load_dwordx4 v[80:83], v58, s[16:19], s56 offen sc1
    s_or_b64 exec, s[90:91], s[20:21]
    buffer_load_dwordx4 v[64:67], v57, s[16:19], s66 offen sc1
    s_or_b64 exec, s[92:93], s[20:21]
    buffer_load_dwordx4 v[68:71], v57, s[16:19], s67 offen sc1
    s_or_b64 exec, s[94:95], s[20:21]
    buffer_load_dwordx4 v[72:75], v57, s[16:19], s68 offen sc1
    s_or_b64 exec, s[96:97], s[20:21]
    buffer_load_dwordx4 v[76:79], v57, s[16:19], s69 offen sc1
    s_or_b32 s4, s98, s99
    s_or_b32 s4, s4, s61
    s_cbranch_scc0 k_fac
k_facret:
    s_waitcnt vmcnt(5)
k_r1:
    s_mov_b64 exec, s[98:99]
    s_cbranch_execz k_x1_4
    v_xor_b32 v32, s62, v100
    v_xor_b32 v33, s62, v101
    v_xor_b32 v34, s62, v102
    v_xor_b32 v35, s62, v103
    v_or3_b32 v60, v32, v33, v34
    v_bitop3_b32 v60, v60, v35, s57 bitop3:0xa8
    v_cmp_ne_u32 s[98:99], 0, v60
k_x1_4:
    s_or_b64 s[4:5], s[98:99], s[22:23]
    s_mov_b64 exec, s[90:91]
    s_cbranch_execz k_x1_0
    v_xor_b32 v16, s62, v84
    v_xor_b32 v17, s62, v85
    v_xor_b32 v18, s62, v86
    v_xor_b32 v19, s62, v87
    v_or3_b32 v60, v16, v17, v18
    v_bitop3_b32 v60, v60, v19, s57 bitop3:0xa8
    v_cmp_ne_u32 s[90:91], 0, v60
k_x1_0:
    s_or_b64 s[4:5], s[90:91], s[4:5]
    s_mov_b64 exec, s[92:93]
    s_cbranch_execz k_x1_1
    v_xor_b32 v20, s62, v88
    v_xor_b32 v21, s62, v89
    v_xor_b32 v22, s62, v90
    v_xor_b32 v23, s62, v91
    v_or3_b32 v60, v20, v21, v22
    v_bitop3_b32 v60, v60, v23, s57 bitop3:0xa8
    v_cmp_ne_u32 s[92:93], 0, v60
k_x1_1:
    s_or_b64 s[4:5], s[92:93], s[4:5]
    s_mov_b64 exec, s[94:95]
    s_cbranch_execz k_x1_2
    v_xor_b32 v24, s62, v92
    v_xor_b32 v25, s62, v93
    v_xor_b32 v26, s62, v94
    v_xor_b32 v27, s62, v95
    v_or3_b32 v60, v24, v25, v26
    v_bitop3_b32 v60, v60, v27, s57 bitop3:0xa8
    v_cmp_ne_u32 s[94:95], 0, v60
k_x1_2:
    s_or_b64 s[4:5], s[94:95], s[4:5]
    s_mov_b64 exec, s[96:97]
    s_cbranch_execz k_x1_3
    v_xor_b32 v28, s62, v96
    v_xor_b32 v29, s62, v97
    v_xor_b32 v30, s62, v98
    v_xor_b32 v31, s62, v99
    v_or3_b32 v60, v28, v29, v30
    v_bitop3_b32 v60, v60, v31, s57 bitop3:0xa8
    v_cmp_ne_u32 s[96:97], 0, v60
k_x1_3:
    s_or_b64 s[4:5], s[96:97], s[4:5]
    s_cbranch_scc0 k_done
    s_or_b64 exec, s[98:99], s[20:21]
    buffer_load_dwordx4 v[100:103], v58, s[16:19], s56 offen sc1
    s_or_b64 exec, s[90:91], s[20:21]
    buffer_load_dwordx4 v[84:87], v57, s[16:19], s66 offen sc1
    s_or_b64 exec, s[92:93], s[20:21]
    buffer_load_dwordx4 v[88:91], v57, s[16:19], s67 offen sc1
    s_or_b64 exec, s[94:95], s[20:21]
    buffer_load_dwordx4 v[92:95], v57, s[16:19], s68 offen sc1
    s_or_b64 exec, s[96:97], s[20:21]
    buffer_load_dwordx4 v[96:99], v57, s[16:19], s69 offen sc1
    s_add_u32 s64, s64, 1
    s_cmp_lt_u32 s64, 100000
    s_waitcnt vmcnt(5)
    s_cbranch_scc1 k_r0
k_done:
    s_mov_b32 s60, 2
    s_cmp_lg_u32 s61, 0
    s_cbranch_scc1 k_acc
k_fac:
    s_mov_b64 exec, -1
    v_lshrrev_b32 v61, 10, v34
    v_or_b32 v63, v32, v61
    v_max_f32 v60, v63, v56
    s_nop 1
    v_max_f32 v60, v60, v60 quad_perm:[1,0,3,2]
    s_nop 1
    v_max_f32 v60, v60, v60 quad_perm:[2,3,0,1]
    s_nop 1
    v_max_f32 v60, v60, v60 row_ror:8
    v_mov_b32 v61, v60
    s_nop 1
    v_permlane16_swap_b32 v60, v61
    v_max_f32 v60, v60, v61
    v_mov_b32 v61, v60
    s_nop 1
    v_permlane32_swap_b32 v60, v61
    v_max_f32 v60, v60, v61
    v_sub_f32 v63, v63, v60
    v_sub_f32 v62, v56, v60
    v_exp_f32 v63, v63
    v_exp_f32 v62, v62
    s_mov_b32 s61, 1
    v_mul_f32 v60, v63, v33
    s_nop 1
    v_add_f32 v60, v60, v60 quad_perm:[1,0,3,2]
    s_nop 1
    v_add_f32 v60, v60, v60 quad_perm:[2,3,0,1]
    s_nop 1
    v_add_f32 v60, v60, v60 row_ror:8
    v_mov_b32 v61, v60
    s_nop 1
    v_permlane16_swap_b32 v60, v61
    v_add_f32 v60, v60, v61
    v_mov_b32 v61, v60
    s_nop 1
    v_permlane32_swap_b32 v60, v61
    v_add_f32 v60, v60, v61
    v_add_f32 v60, v60, v62
    v_rcp_f32 v60, v60
    s_cmp_eq_u32 s60, 1
    v_mul_f32 v63, v63, v60
    v_mul_f32 v62, v62, v60
    v_mul_f32 v48, v62, v52
    v_mul_f32 v49, v62, v53
    v_mul_f32 v50, v62, v54
    v_mul_f32 v51, v62, v55
    v_mov_b32 v36, v63 quad_perm:[0,0,0,0]
    v_mov_b32 v38, v63 quad_perm:[1,1,1,1]
    v_mov_b32 v40, v63 quad_perm:[2,2,2,2]
    v_mov_b32 v42, v63 quad_perm:[3,3,3,3]
    s_cbranch_scc1 k_facret
k_acc:
    s_mov_b64 exec, -1
    v_pk_fma_f32 v[44:45], v[16:17], v[36:37], v[48:49] op_sel_hi:[1,0,1]
    v_pk_fma_f32 v[46:47], v[18:19], v[36:37], v[50:51] op_sel_hi:[1,0,1]
    v_pk_fma_f32 v[44:45], v[20:21], v[38:39], v[44:45] op_sel_hi:[1,0,1]
    v_pk_fma_f32 v[46:47], v[22:23], v[38:39], v[46:47] op_sel_hi:[1,0,1]
    v_pk_fma_f32 v[44:45], v[24:25], v[40:41], v[44:45] op_sel_hi:[1,0,1]
    v_pk_fma_f32 v[46:47], v[26:27], v[40:41], v[46:47] op_sel_hi:[1,0,1]
    v_pk_fma_f32 v[44:45], v[28:29], v[42:43], v[44:45] op_sel_hi:[1,0,1]
    v_pk_fma_f32 v[46:47], v[30:31], v[42:43], v[46:47] op_sel_hi:[1,0,1]
    s_nop 1
    v_permlane32_swap_b32 v44, v46
    v_permlane32_swap_b32 v45, v47
    v_pk_add_f32 v[44:45], v[44:45], v[46:47]
    s_nop 1
    v_permlane16_swap_b32 v44, v45
    v_add_f32 v44, v44, v45
    s_nop 1
    v_add_f32 v44, v44, v44 row_ror:8
    s_mov_b64 exec, s[42:43]
    v_cvt_pk_bf16_f32 v44, v44, v44
    buffer_store_short v44, v59, s[12:15], s58 offen
    s_mov_b64 exec, s[88:89]
    buffer_store_dword v11, v12, s[16:19], s54 offen
    s_endpgm
.section .rodata,"a"
.p2align 6
.amdhsa_kernel standalone__tree_speculative_verify_tree_attention_over_candidate_token_tree__decode_kernel
  .amdhsa_next_free_vgpr 168
  .amdhsa_next_free_sgpr 100
  .amdhsa_accum_offset 168
  .amdhsa_group_segment_fixed_size 0
  .amdhsa_kernarg_size 72
  .amdhsa_user_sgpr_count 2
  .amdhsa_user_sgpr_kernarg_segment_ptr 1
  .amdhsa_system_sgpr_workgroup_id_x 1
.end_amdhsa_kernel
```
